```python
import torch

def _softmax(x, axis=-1):
    return torch.softmax(x, dim=axis)
def _gelu(x):
    return torch.nn.functional.gelu(x, approximate="tanh")
def _silu(x):
    return torch.nn.functional.silu(x)
def _sigmoid(x):
    return torch.sigmoid(x)
def _layernorm(x, axis=-1, eps=1e-5):
    m = x.mean(dim=axis, keepdim=True)
    v = x.var(dim=axis, keepdim=True, unbiased=False)
    return (x - m) / torch.sqrt(v + eps)
def _scatter_add(tgt, idx, src, axis=0):
    return tgt.clone().index_add_(axis, idx, src)
def _segment_sum(src, seg, n):
    out = torch.zeros((n,) + src.shape[1:], dtype=src.dtype)
    return out.index_add_(0, seg, src)
def _pad(x, pw):
    flat = tuple(v for pair in reversed(pw) for v in pair)
    return torch.nn.functional.pad(x, flat)

kernel_name = 'standalone__linear_kernel_rfa__decode'

def setup_inputs():

    _w = (lambda a: (lambda t: t.to(torch.bfloat16) if t.is_floating_point() else t)(torch.as_tensor(a)))
    B, H, Sq, Sk, D, M = 4, 32, 1, 8192, 128, 8
    return {
        "q": _w((lambda *s: torch.randn(*s, dtype=torch.bfloat16) * 0.05)(B, H, Sq, D)),
        "k": _w((lambda *s: torch.randn(*s, dtype=torch.bfloat16) * 0.4)(B, H, Sk, D)),
        "v": _w((lambda *s: torch.randn(*s, dtype=torch.bfloat16) * 0.4)(B, H, Sk, D)),
        "omega": _w((lambda *s: torch.randn(*s, dtype=torch.bfloat16) * 0.8)(M, D)),
    }

def reference(q, k, v, omega):
    d = q.shape[-1]
    m = omega.shape[0]
    scale = float(d) ** -0.25
    qs = q * scale
    ks = k * scale
    q_proj = torch.einsum("bhsd,md->bhsm", qs, omega)
    k_proj = torch.einsum("bhsd,md->bhsm", ks, omega)
    q_sq = 0.5 * torch.einsum("bhsd,bhsd->bhs", qs, qs)[..., None]
    k_sq = 0.5 * torch.einsum("bhsd,bhsd->bhs", ks, ks)[..., None]
    inv_sqrt_m = float(m) ** -0.5
    phi_q = torch.exp(q_proj - q_sq) * inv_sqrt_m + 1e-6
    phi_k = torch.exp(k_proj - k_sq) * inv_sqrt_m + 1e-6
    kv = torch.einsum("bhsm,bhsd->bhmd", phi_k, v)
    z  = torch.einsum("bhsm->bhm", phi_k)
    num = torch.einsum("bhqm,bhmd->bhqd", phi_q, kv)
    den = torch.einsum("bhqm,bhm->bhq", phi_q, z)[..., None] + 1e-6
    return num / den
```

```asm
; @launch grid=(256,1,1) block=(256,1,1) lds=131136
.amdgcn_target "amdgcn-amd-amdhsa--gfx950"
.text
.globl standalone__linear_kernel_rfa__decode_kernel
.p2align 8
.type standalone__linear_kernel_rfa__decode_kernel,@function
standalone__linear_kernel_rfa__decode_kernel:
s_load_dwordx8 s[4:11], s[0:1], 0
s_load_dwordx4 s[12:15], s[0:1], 32
s_load_dwordx2 s[16:17], s[0:1], 48
s_cmp_ge_u32 s2, 256
s_cbranch_scc1 L_done
v_lshrrev_b32 v4, 6, v0
v_and_b32 v1, 63, v0
v_and_b32 v5, 15, v1
v_lshrrev_b32 v6, 4, v1
v_readfirstlane_b32 s37, v4
v_and_b32 v4, 3, v5
v_lshlrev_b32 v7, 10, v4
v_lshrrev_b32 v128, 2, v5
v_lshlrev_b32 v129, 8, v128
v_lshlrev_b32 v130, 4, v6
v_add3_u32 v2, v7, v129, v130
v_lshlrev_b32 v3, 4, v1
s_lshr_b32 s3, s2, 1
s_lshl_b32 s96, s3, 21
s_and_b32 s99, s2, 1
s_bfe_u32 s18, s37, 0x10001
s_lshl_b32 s18, s18, 13
s_add_u32 s96, s96, s18
s_and_b32 s18, s37, 1
s_lshl_b32 s18, s18, 15
s_add_u32 s96, s96, s18
s_mov_b32 s18, s99
s_lshl_b32 s18, s18, 16
s_add_u32 s96, s96, s18
s_mov_b32 s97, 0
s_mov_b32 s98, 0
s_mov_b32 s36, s96
s_mov_b32 s39, s96
s_lshl_b32 s19, s3, 8
s_mov_b32 s22, 0x10000000
s_mov_b32 s23, 0x20000
s_mov_b32 s26, 0x10000000
s_mov_b32 s27, 0x20000
s_mov_b32 s30, 2048
s_mov_b32 s31, 0x20000
s_mov_b32 s34, 32768
s_mov_b32 s35, 0x20000
s_mul_i32 s53, s37, 16384
s_add_u32 s53, s53, 65536
v_lshlrev_b32 v131, 2, v6
v_lshlrev_b32 v132, 8, v6
v_add_u32 v133, 0, v131
v_xor_b32 v133, v133, v5
v_lshl_add_u32 v118, v133, 4, v132
v_add_u32 v133, 1, v131
v_xor_b32 v133, v133, v5
v_lshl_add_u32 v119, v133, 4, v132
v_add_u32 v133, 2, v131
v_xor_b32 v133, v133, v5
v_lshl_add_u32 v120, v133, 4, v132
v_add_u32 v133, 3, v131
v_xor_b32 v133, v133, v5
v_lshl_add_u32 v121, v133, 4, v132
v_and_b32 v134, 7, v1
v_lshlrev_b32 v134, 8, v134
v_add_u32 v134, v134, v130
s_waitcnt lgkmcnt(0)
s_mov_b32 s20, s6
s_mov_b32 s21, s7
s_mov_b32 s24, s8
s_mov_b32 s25, s9
s_mov_b32 s28, s10
s_mov_b32 s29, s11
s_mov_b32 s32, s4
s_mov_b32 s33, s5
buffer_load_dwordx4 v[8:11], v134, s[28:31], 0 offen offset:0
buffer_load_dwordx4 v[12:15], v134, s[28:31], 0 offen offset:64
buffer_load_dwordx4 v[16:19], v134, s[28:31], 0 offen offset:128
buffer_load_dwordx4 v[20:23], v134, s[28:31], 0 offen offset:192
buffer_load_dwordx4 v[136:139], v130, s[32:35], s19 offen offset:0
buffer_load_dwordx4 v[140:143], v130, s[32:35], s19 offen offset:64
buffer_load_dwordx4 v[144:147], v130, s[32:35], s19 offen offset:128
buffer_load_dwordx4 v[148:151], v130, s[32:35], s19 offen offset:192
s_add_u32 m0, s53, 8192
s_nop 0
buffer_load_dwordx4 v118, s[20:23], s36 offen offset:0 nt lds
buffer_load_dwordx4 v119, s[20:23], s36 offen offset:1024 nt lds
buffer_load_dwordx4 v120, s[20:23], s36 offen offset:2048 nt lds
buffer_load_dwordx4 v121, s[20:23], s36 offen offset:3072 nt lds
s_add_u32 s97, s97, 1
s_mov_b32 s36, s96
s_bfe_u32 s18, s97, 0x10000
s_lshl_b32 s18, s18, 12
s_add_u32 s36, s36, s18
s_bfe_u32 s18, s97, 0x10001
s_lshl_b32 s18, s18, 14
s_add_u32 s36, s36, s18
s_bfe_u32 s18, s97, 0x40002
s_lshl_b32 s18, s18, 17
s_add_u32 s36, s36, s18
s_add_u32 m0, s53, 0
s_nop 0
buffer_load_dwordx4 v118, s[20:23], s36 offen offset:0 nt lds
buffer_load_dwordx4 v119, s[20:23], s36 offen offset:1024 nt lds
buffer_load_dwordx4 v120, s[20:23], s36 offen offset:2048 nt lds
buffer_load_dwordx4 v121, s[20:23], s36 offen offset:3072 nt lds
s_add_u32 s97, s97, 1
s_mov_b32 s36, s96
s_bfe_u32 s18, s97, 0x10000
s_lshl_b32 s18, s18, 12
s_add_u32 s36, s36, s18
s_bfe_u32 s18, s97, 0x10001
s_lshl_b32 s18, s18, 14
s_add_u32 s36, s36, s18
s_bfe_u32 s18, s97, 0x40002
s_lshl_b32 s18, s18, 17
s_add_u32 s36, s36, s18
s_add_u32 m0, s53, 12288
s_nop 0
buffer_load_dwordx4 v118, s[20:23], s36 offen offset:0 nt lds
buffer_load_dwordx4 v119, s[20:23], s36 offen offset:1024 nt lds
buffer_load_dwordx4 v120, s[20:23], s36 offen offset:2048 nt lds
buffer_load_dwordx4 v121, s[20:23], s36 offen offset:3072 nt lds
s_add_u32 s97, s97, 1
s_mov_b32 s36, s96
s_bfe_u32 s18, s97, 0x10000
s_lshl_b32 s18, s18, 12
s_add_u32 s36, s36, s18
s_bfe_u32 s18, s97, 0x10001
s_lshl_b32 s18, s18, 14
s_add_u32 s36, s36, s18
s_bfe_u32 s18, s97, 0x40002
s_lshl_b32 s18, s18, 17
s_add_u32 s36, s36, s18
s_add_u32 m0, s53, 4096
s_nop 0
buffer_load_dwordx4 v118, s[20:23], s36 offen offset:0 nt lds
buffer_load_dwordx4 v119, s[20:23], s36 offen offset:1024 nt lds
buffer_load_dwordx4 v120, s[20:23], s36 offen offset:2048 nt lds
buffer_load_dwordx4 v121, s[20:23], s36 offen offset:3072 nt lds
s_add_u32 s97, s97, 1
s_mov_b32 s36, s96
s_bfe_u32 s18, s97, 0x10000
s_lshl_b32 s18, s18, 12
s_add_u32 s36, s36, s18
s_bfe_u32 s18, s97, 0x10001
s_lshl_b32 s18, s18, 14
s_add_u32 s36, s36, s18
s_bfe_u32 s18, s97, 0x40002
s_lshl_b32 s18, s18, 17
s_add_u32 s36, s36, s18
v_and_b32 v4, 3, v5
v_xor_b32 v4, v4, v6
v_lshrrev_b32 v7, 2, v5
v_and_b32 v128, 3, v5
v_lshlrev_b32 v128, 10, v128
v_lshl_add_u32 v128, v7, 8, v128
v_add_u32 v128, s53, v128
v_xor_b32 v129, 0, v7
v_lshl_add_u32 v129, v129, 2, v4
v_lshl_add_u32 v122, v129, 4, v128
v_xor_b32 v129, 1, v7
v_lshl_add_u32 v129, v129, 2, v4
v_lshl_add_u32 v123, v129, 4, v128
v_xor_b32 v129, 2, v7
v_lshl_add_u32 v129, v129, 2, v4
v_lshl_add_u32 v124, v129, 4, v128
v_xor_b32 v129, 3, v7
v_lshl_add_u32 v129, v129, 2, v4
v_lshl_add_u32 v125, v129, 4, v128
v_and_b32 v4, 7, v1
v_lshl_add_u32 v4, v6, 3, v4
v_lshlrev_b32 v4, 3, v4
s_mul_i32 s18, s37, 16384
v_add_u32 v126, s18, v4
v_mov_b32 v127, v126
s_mov_b32 s44, s16
s_mov_b32 s45, s17
s_mov_b32 s46, 1343488
s_mov_b32 s47, 0x20000
s_mov_b32 s48, s14
s_mov_b32 s49, s15
s_mov_b32 s50, 256
s_mov_b32 s51, 0x20000
s_lshl_b32 s52, s2, 10
s_add_u32 s52, s52, 1048576
s_xor_b32 s54, s52, 1024
s_mov_b32 s40, 0x05040100
s_mov_b32 s41, 0x07060302
s_mov_b32 s42, 0x3edb9ada
s_mov_b32 s43, 0x358637bd
s_or_b32 s56, s2, s37
s_cmp_lg_u32 s56, 0
s_cbranch_scc1 L_notag
s_memrealtime s[56:57]
s_waitcnt lgkmcnt(0)
s_or_b32 s56, s56, 1
v_mov_b32 v154, s56
v_mov_b32 v155, 0
v_mov_b32 v4, 0
s_mov_b64 exec, 1
buffer_atomic_cmpswap v[154:155], v4, s[48:51], 0 offen
s_mov_b64 exec, -1
L_notag:
v_mov_b32 v24, 0
v_mov_b32 v25, 0
v_mov_b32 v26, 0
v_mov_b32 v27, 0
v_mov_b32 v28, 0
v_mov_b32 v29, 0
v_mov_b32 v30, 0
v_mov_b32 v31, 0
v_mov_b32 v32, 0
v_mov_b32 v33, 0
v_mov_b32 v34, 0
v_mov_b32 v35, 0
v_mov_b32 v36, 0
v_mov_b32 v37, 0
v_mov_b32 v38, 0
v_mov_b32 v39, 0
v_mov_b32 v40, 0
v_mov_b32 v41, 0
v_mov_b32 v42, 0
v_mov_b32 v43, 0
v_mov_b32 v44, 0
v_mov_b32 v45, 0
v_mov_b32 v46, 0
v_mov_b32 v47, 0
v_mov_b32 v48, 0
v_mov_b32 v49, 0
v_mov_b32 v50, 0
v_mov_b32 v51, 0
v_mov_b32 v52, 0
v_mov_b32 v53, 0
v_mov_b32 v54, 0
v_mov_b32 v55, 0
v_mov_b32 v88, 0
v_mov_b32 v89, 0
v_mov_b32 v90, 0
v_mov_b32 v91, 0
v_mov_b32 v100, 0xbfc00000
v_mov_b32 v101, 0xbfc00000
v_mov_b32 v102, 0xbfc00000
v_mov_b32 v103, 0xbfc00000
v_mov_b32 v112, 0x3f803f80
v_mov_b32 v113, 0x3f803f80
v_mov_b32 v116, 0xbd8293ee
s_mov_b32 s57, 0
s_mov_b32 s58, 0
s_mov_b32 s59, 0
s_mov_b32 s79, 0
s_mov_b32 s55, 0
s_mov_b32 s87, 0
s_mov_b32 s80, 0
s_mov_b32 s81, 0
s_mov_b32 s82, 0
s_mov_b32 s83, 0
s_mov_b32 s58, 1
s_mov_b32 s59, 1
s_mov_b32 s93, 40
s_mov_b32 s84, 167
v_mov_b32 v153, 131072
v_mov_b32 v4, 0
ds_write_b32 v153, v4
s_waitcnt vmcnt(16)
v_mfma_f32_16x16x32_bf16 v[92:95], v[8:11], v[136:139], 0
v_mfma_f32_16x16x32_bf16 v[92:95], v[12:15], v[140:143], v[92:95]
v_mfma_f32_16x16x32_bf16 v[92:95], v[16:19], v[144:147], v[92:95]
v_mfma_f32_16x16x32_bf16 v[92:95], v[20:23], v[148:151], v[92:95]
v_dot2_f32_bf16 v114, v136, v136, 0
v_dot2_f32_bf16 v115, v137, v137, 0
v_dot2_f32_bf16 v114, v138, v138, v114
v_dot2_f32_bf16 v115, v139, v139, v115
v_dot2_f32_bf16 v114, v140, v140, v114
v_dot2_f32_bf16 v115, v141, v141, v115
v_dot2_f32_bf16 v114, v142, v142, v114
v_dot2_f32_bf16 v115, v143, v143, v115
v_dot2_f32_bf16 v114, v144, v144, v114
v_dot2_f32_bf16 v115, v145, v145, v115
v_dot2_f32_bf16 v114, v146, v146, v114
v_dot2_f32_bf16 v115, v147, v147, v115
v_dot2_f32_bf16 v114, v148, v148, v114
v_dot2_f32_bf16 v115, v149, v149, v115
v_dot2_f32_bf16 v114, v150, v150, v114
v_dot2_f32_bf16 v115, v151, v151, v115
s_nop 2
v_add_f32 v114, v114, v115
s_nop 1
v_mfma_f32_16x16x4_f32 v[96:99], v116, v114, v[100:103]
s_nop 10
v_fma_f32 v104, v92, s42, v96
v_fma_f32 v105, v93, s42, v97
v_fma_f32 v106, v94, s42, v98
v_fma_f32 v107, v95, s42, v99
v_exp_f32 v104, v104
v_exp_f32 v105, v105
v_exp_f32 v106, v106
v_exp_f32 v107, v107
v_add_f32 v104, s43, v104
v_add_f32 v105, s43, v105
v_add_f32 v106, s43, v106
v_add_f32 v107, s43, v107
v_cmp_gt_u32 vcc, 32, v1
s_nop 1
v_cndmask_b32 v104, 0, v104, vcc
v_cndmask_b32 v105, 0, v105, vcc
v_cndmask_b32 v106, 0, v106, vcc
v_cndmask_b32 v107, 0, v107, vcc
s_mov_b32 s38, 15
L_kloop:
s_memrealtime s[60:61]
s_cmp_lg_u32 s79, 10
s_cbranch_scc1 L_rl3
v_and_b32 v4, 7, v1
v_lshlrev_b32 v4, 3, v4
s_mov_b32 s86, 1310720
buffer_load_dwordx2 v[236:237], v4, s[44:47], s86 offen
L_rl3:
s_cmp_lg_u32 s79, 1
s_cbranch_scc1 L_st1
v_mov_b32 v4, 0
buffer_load_dword v152, v4, s[48:51], 0 offen
L_st1:
s_cmp_lg_u32 s79, 2
s_cbranch_scc1 L_st2
v_readfirstlane_b32 s55, v152
L_st2:
s_waitcnt vmcnt(12)
s_cmp_eq_u32 s58, 0
s_cbranch_scc1 L_km4
ds_read_b128 v[156:159], v122 offset:8192
ds_read_b128 v[160:163], v123 offset:8192
ds_read_b128 v[164:167], v124 offset:8192
ds_read_b128 v[168:171], v125 offset:8192
s_waitcnt lgkmcnt(0)
L_km4:
v_mfma_f32_16x16x32_bf16 v[92:95], v[156:159], v[8:11], 0
v_mfma_f32_16x16x32_bf16 v[92:95], v[160:163], v[12:15], v[92:95]
v_mfma_f32_16x16x32_bf16 v[92:95], v[164:167], v[16:19], v[92:95]
v_mfma_f32_16x16x32_bf16 v[92:95], v[168:171], v[20:23], v[92:95]
v_dot2_f32_bf16 v114, v156, v156, 0
v_dot2_f32_bf16 v115, v157, v157, 0
v_dot2_f32_bf16 v114, v158, v158, v114
v_dot2_f32_bf16 v115, v159, v159, v115
v_dot2_f32_bf16 v114, v160, v160, v114
v_dot2_f32_bf16 v115, v161, v161, v115
v_dot2_f32_bf16 v114, v162, v162, v114
v_dot2_f32_bf16 v115, v163, v163, v115
v_dot2_f32_bf16 v114, v164, v164, v114
v_dot2_f32_bf16 v115, v165, v165, v115
v_dot2_f32_bf16 v114, v166, v166, v114
v_dot2_f32_bf16 v115, v167, v167, v115
v_dot2_f32_bf16 v114, v168, v168, v114
v_dot2_f32_bf16 v115, v169, v169, v115
v_dot2_f32_bf16 v114, v170, v170, v114
v_dot2_f32_bf16 v115, v171, v171, v115
s_cmp_lg_u32 s57, 0
s_cbranch_scc1 L_big5
buffer_load_dwordx4 v[156:159], v2, s[20:23], s36 offen offset:0 nt
buffer_load_dwordx4 v[160:163], v2, s[20:23], s36 offen offset:64 nt
buffer_load_dwordx4 v[164:167], v2, s[20:23], s36 offen offset:128 nt
buffer_load_dwordx4 v[168:171], v2, s[20:23], s36 offen offset:192 nt
s_mov_b32 s58, 0
s_branch L_cj6
L_big5:
s_add_u32 m0, s53, 8192
s_nop 0
buffer_load_dwordx4 v118, s[20:23], s36 offen offset:0 nt lds
buffer_load_dwordx4 v119, s[20:23], s36 offen offset:1024 nt lds
buffer_load_dwordx4 v120, s[20:23], s36 offen offset:2048 nt lds
buffer_load_dwordx4 v121, s[20:23], s36 offen offset:3072 nt lds
s_mov_b32 s58, 1
s_sub_u32 s57, s57, 1
L_cj6:
s_add_u32 s97, s97, 1
s_mov_b32 s36, s96
s_bfe_u32 s18, s97, 0x10000
s_lshl_b32 s18, s18, 12
s_add_u32 s36, s36, s18
s_bfe_u32 s18, s97, 0x10001
s_lshl_b32 s18, s18, 14
s_add_u32 s36, s36, s18
s_bfe_u32 s18, s97, 0x40002
s_lshl_b32 s18, s18, 17
s_add_u32 s36, s36, s18
v_add_f32 v114, v114, v115
s_nop 1
v_mfma_f32_16x16x4_f32 v[96:99], v114, v116, v[100:103]
s_nop 9
v_fma_f32 v128, v92, s42, v96
v_fma_f32 v129, v93, s42, v97
v_fma_f32 v130, v94, s42, v98
v_fma_f32 v131, v95, s42, v99
v_exp_f32 v128, v128
v_exp_f32 v129, v129
v_exp_f32 v130, v130
v_exp_f32 v131, v131
v_add_f32 v128, s43, v128
v_add_f32 v129, s43, v129
v_add_f32 v130, s43, v130
v_add_f32 v131, s43, v131
v_cvt_pk_bf16_f32 v108, v128, v129
v_cvt_pk_bf16_f32 v109, v130, v131
ds_write_b64 v126, v[108:109]
v_add_u32 v126, 256, v126
v_mfma_f32_16x16x16_bf16 v[88:91], v[108:109], v[112:113], v[88:91]
s_waitcnt vmcnt(12)
ds_read_b128 v[220:223], v122 offset:0
ds_read_b128 v[224:227], v123 offset:0
ds_read_b128 v[228:231], v124 offset:0
ds_read_b128 v[232:235], v125 offset:0
s_waitcnt lgkmcnt(0)
s_add_u32 m0, s53, 0
s_nop 0
buffer_load_dwordx4 v118, s[20:23], s36 offen offset:0 nt lds
buffer_load_dwordx4 v119, s[20:23], s36 offen offset:1024 nt lds
buffer_load_dwordx4 v120, s[20:23], s36 offen offset:2048 nt lds
buffer_load_dwordx4 v121, s[20:23], s36 offen offset:3072 nt lds
s_add_u32 s97, s97, 1
s_mov_b32 s36, s96
s_bfe_u32 s18, s97, 0x10000
s_lshl_b32 s18, s18, 12
s_add_u32 s36, s36, s18
s_bfe_u32 s18, s97, 0x10001
s_lshl_b32 s18, s18, 14
s_add_u32 s36, s36, s18
s_bfe_u32 s18, s97, 0x40002
s_lshl_b32 s18, s18, 17
s_add_u32 s36, s36, s18
v_mfma_f32_16x16x32_bf16 v[92:95], v[220:223], v[8:11], 0
v_mfma_f32_16x16x32_bf16 v[92:95], v[224:227], v[12:15], v[92:95]
v_mfma_f32_16x16x32_bf16 v[92:95], v[228:231], v[16:19], v[92:95]
v_mfma_f32_16x16x32_bf16 v[92:95], v[232:235], v[20:23], v[92:95]
v_dot2_f32_bf16 v114, v220, v220, 0
v_dot2_f32_bf16 v115, v221, v221, 0
v_dot2_f32_bf16 v114, v222, v222, v114
v_dot2_f32_bf16 v115, v223, v223, v115
v_dot2_f32_bf16 v114, v224, v224, v114
v_dot2_f32_bf16 v115, v225, v225, v115
v_dot2_f32_bf16 v114, v226, v226, v114
v_dot2_f32_bf16 v115, v227, v227, v115
v_dot2_f32_bf16 v114, v228, v228, v114
v_dot2_f32_bf16 v115, v229, v229, v115
v_dot2_f32_bf16 v114, v230, v230, v114
v_dot2_f32_bf16 v115, v231, v231, v115
v_dot2_f32_bf16 v114, v232, v232, v114
v_dot2_f32_bf16 v115, v233, v233, v115
v_dot2_f32_bf16 v114, v234, v234, v114
v_dot2_f32_bf16 v115, v235, v235, v115
s_nop 2
v_add_f32 v114, v114, v115
s_nop 1
v_mfma_f32_16x16x4_f32 v[96:99], v114, v116, v[100:103]
s_nop 9
v_fma_f32 v128, v92, s42, v96
v_fma_f32 v129, v93, s42, v97
v_fma_f32 v130, v94, s42, v98
v_fma_f32 v131, v95, s42, v99
v_exp_f32 v128, v128
v_exp_f32 v129, v129
v_exp_f32 v130, v130
v_exp_f32 v131, v131
v_add_f32 v128, s43, v128
v_add_f32 v129, s43, v129
v_add_f32 v130, s43, v130
v_add_f32 v131, s43, v131
v_cvt_pk_bf16_f32 v108, v128, v129
v_cvt_pk_bf16_f32 v109, v130, v131
ds_write_b64 v126, v[108:109]
v_add_u32 v126, 256, v126
v_mfma_f32_16x16x16_bf16 v[88:91], v[108:109], v[112:113], v[88:91]
s_mov_b32 s57, 0
s_cmp_eq_u32 s55, 0
s_cbranch_scc1 L_sp7
s_sub_u32 s60, s60, s55
s_sub_u32 s60, s60, s84
s_cmp_lg_u32 s79, 8
s_cbranch_scc1 L_rp8
s_cmp_lg_u32 s37, 0
s_cbranch_scc1 L_rp8
s_mul_i32 s61, s2, 1986
s_lshr_b32 s61, s61, 16
s_mul_i32 s85, s61, 33
s_cmp_lg_u32 s85, s2
s_cbranch_scc1 L_rp8
s_add_u32 s85, s60, 1048576
s_xor_b32 s86, s85, s55
v_mov_b32 v236, s85
v_mov_b32 v237, s86
s_lshl_b32 s61, s61, 3
v_mov_b32 v4, s61
s_mov_b32 s86, 1310720
s_mov_b64 exec, 1
buffer_store_dwordx2 v[236:237], v4, s[44:47], s86 offen sc1
s_mov_b64 exec, -1
L_rp8:
s_cmp_lg_u32 s79, 11
s_cbranch_scc1 L_rc9
s_mov_b32 s85, 0
s_mov_b32 s86, 0
v_readlane_b32 s61, v236, 0
v_readlane_b32 s94, v237, 0
s_nop 0
s_xor_b32 s94, s94, s61
s_cmp_eq_u32 s94, s55
s_cselect_b32 s61, s61, 0
s_cselect_b32 s94, 1, 0
s_add_u32 s85, s85, s61
s_add_u32 s86, s86, s94
v_readlane_b32 s61, v236, 1
v_readlane_b32 s94, v237, 1
s_nop 0
s_xor_b32 s94, s94, s61
s_cmp_eq_u32 s94, s55
s_cselect_b32 s61, s61, 0
s_cselect_b32 s94, 1, 0
s_add_u32 s85, s85, s61
s_add_u32 s86, s86, s94
v_readlane_b32 s61, v236, 2
v_readlane_b32 s94, v237, 2
s_nop 0
s_xor_b32 s94, s94, s61
s_cmp_eq_u32 s94, s55
s_cselect_b32 s61, s61, 0
s_cselect_b32 s94, 1, 0
s_add_u32 s85, s85, s61
s_add_u32 s86, s86, s94
v_readlane_b32 s61, v236, 3
v_readlane_b32 s94, v237, 3
s_nop 0
s_xor_b32 s94, s94, s61
s_cmp_eq_u32 s94, s55
s_cselect_b32 s61, s61, 0
s_cselect_b32 s94, 1, 0
s_add_u32 s85, s85, s61
s_add_u32 s86, s86, s94
v_readlane_b32 s61, v236, 4
v_readlane_b32 s94, v237, 4
s_nop 0
s_xor_b32 s94, s94, s61
s_cmp_eq_u32 s94, s55
s_cselect_b32 s61, s61, 0
s_cselect_b32 s94, 1, 0
s_add_u32 s85, s85, s61
s_add_u32 s86, s86, s94
v_readlane_b32 s61, v236, 5
v_readlane_b32 s94, v237, 5
s_nop 0
s_xor_b32 s94, s94, s61
s_cmp_eq_u32 s94, s55
s_cselect_b32 s61, s61, 0
s_cselect_b32 s94, 1, 0
s_add_u32 s85, s85, s61
s_add_u32 s86, s86, s94
v_readlane_b32 s61, v236, 6
v_readlane_b32 s94, v237, 6
s_nop 0
s_xor_b32 s94, s94, s61
s_cmp_eq_u32 s94, s55
s_cselect_b32 s61, s61, 0
s_cselect_b32 s94, 1, 0
s_add_u32 s85, s85, s61
s_add_u32 s86, s86, s94
v_readlane_b32 s61, v236, 7
v_readlane_b32 s94, v237, 7
s_nop 0
s_xor_b32 s94, s94, s61
s_cmp_eq_u32 s94, s55
s_cselect_b32 s61, s61, 0
s_cselect_b32 s94, 1, 0
s_add_u32 s85, s85, s61
s_add_u32 s86, s86, s94
s_cmp_lt_u32 s86, 8
s_cbranch_scc1 L_rc9
s_lshr_b32 s85, s85, 3
s_sub_u32 s85, s85, 1048576
s_add_u32 s84, s84, s85
s_sub_u32 s60, s60, s85
L_rc9:
s_cmp_gt_i32 s60, 100
s_cselect_b32 s57, 2, 0
s_min_u32 s57, s57, s93
s_sub_u32 s93, s93, s57
L_sp7:
s_cmp_ge_u32 s79, 28
s_cselect_b32 s57, 2, s57
s_add_u32 s84, s84, 215
s_waitcnt vmcnt(12)
s_cmp_eq_u32 s59, 0
s_cbranch_scc1 L_km10
ds_read_b128 v[172:175], v122 offset:12288
ds_read_b128 v[176:179], v123 offset:12288
ds_read_b128 v[180:183], v124 offset:12288
ds_read_b128 v[184:187], v125 offset:12288
s_waitcnt lgkmcnt(0)
L_km10:
v_mfma_f32_16x16x32_bf16 v[92:95], v[172:175], v[8:11], 0
v_mfma_f32_16x16x32_bf16 v[92:95], v[176:179], v[12:15], v[92:95]
v_mfma_f32_16x16x32_bf16 v[92:95], v[180:183], v[16:19], v[92:95]
v_mfma_f32_16x16x32_bf16 v[92:95], v[184:187], v[20:23], v[92:95]
v_dot2_f32_bf16 v114, v172, v172, 0
v_dot2_f32_bf16 v115, v173, v173, 0
v_dot2_f32_bf16 v114, v174, v174, v114
v_dot2_f32_bf16 v115, v175, v175, v115
v_dot2_f32_bf16 v114, v176, v176, v114
v_dot2_f32_bf16 v115, v177, v177, v115
v_dot2_f32_bf16 v114, v178, v178, v114
v_dot2_f32_bf16 v115, v179, v179, v115
v_dot2_f32_bf16 v114, v180, v180, v114
v_dot2_f32_bf16 v115, v181, v181, v115
v_dot2_f32_bf16 v114, v182, v182, v114
v_dot2_f32_bf16 v115, v183, v183, v115
v_dot2_f32_bf16 v114, v184, v184, v114
v_dot2_f32_bf16 v115, v185, v185, v115
v_dot2_f32_bf16 v114, v186, v186, v114
v_dot2_f32_bf16 v115, v187, v187, v115
s_cmp_lg_u32 s57, 0
s_cbranch_scc1 L_big11
buffer_load_dwordx4 v[172:175], v2, s[20:23], s36 offen offset:0 nt
buffer_load_dwordx4 v[176:179], v2, s[20:23], s36 offen offset:64 nt
buffer_load_dwordx4 v[180:183], v2, s[20:23], s36 offen offset:128 nt
buffer_load_dwordx4 v[184:187], v2, s[20:23], s36 offen offset:192 nt
s_mov_b32 s59, 0
s_branch L_cj12
L_big11:
s_add_u32 m0, s53, 12288
s_nop 0
buffer_load_dwordx4 v118, s[20:23], s36 offen offset:0 nt lds
buffer_load_dwordx4 v119, s[20:23], s36 offen offset:1024 nt lds
buffer_load_dwordx4 v120, s[20:23], s36 offen offset:2048 nt lds
buffer_load_dwordx4 v121, s[20:23], s36 offen offset:3072 nt lds
s_mov_b32 s59, 1
s_sub_u32 s57, s57, 1
L_cj12:
s_add_u32 s97, s97, 1
s_mov_b32 s36, s96
s_bfe_u32 s18, s97, 0x10000
s_lshl_b32 s18, s18, 12
s_add_u32 s36, s36, s18
s_bfe_u32 s18, s97, 0x10001
s_lshl_b32 s18, s18, 14
s_add_u32 s36, s36, s18
s_bfe_u32 s18, s97, 0x40002
s_lshl_b32 s18, s18, 17
s_add_u32 s36, s36, s18
v_add_f32 v114, v114, v115
s_nop 1
v_mfma_f32_16x16x4_f32 v[96:99], v114, v116, v[100:103]
s_nop 9
v_fma_f32 v128, v92, s42, v96
v_fma_f32 v129, v93, s42, v97
v_fma_f32 v130, v94, s42, v98
v_fma_f32 v131, v95, s42, v99
v_exp_f32 v128, v128
v_exp_f32 v129, v129
v_exp_f32 v130, v130
v_exp_f32 v131, v131
v_add_f32 v128, s43, v128
v_add_f32 v129, s43, v129
v_add_f32 v130, s43, v130
v_add_f32 v131, s43, v131
v_cvt_pk_bf16_f32 v108, v128, v129
v_cvt_pk_bf16_f32 v109, v130, v131
ds_write_b64 v126, v[108:109]
v_add_u32 v126, 256, v126
v_mfma_f32_16x16x16_bf16 v[88:91], v[108:109], v[112:113], v[88:91]
s_waitcnt vmcnt(12)
ds_read_b128 v[220:223], v122 offset:4096
ds_read_b128 v[224:227], v123 offset:4096
ds_read_b128 v[228:231], v124 offset:4096
ds_read_b128 v[232:235], v125 offset:4096
s_waitcnt lgkmcnt(0)
s_add_u32 m0, s53, 4096
s_nop 0
buffer_load_dwordx4 v118, s[20:23], s36 offen offset:0 nt lds
buffer_load_dwordx4 v119, s[20:23], s36 offen offset:1024 nt lds
buffer_load_dwordx4 v120, s[20:23], s36 offen offset:2048 nt lds
buffer_load_dwordx4 v121, s[20:23], s36 offen offset:3072 nt lds
s_add_u32 s97, s97, 1
s_mov_b32 s36, s96
s_bfe_u32 s18, s97, 0x10000
s_lshl_b32 s18, s18, 12
s_add_u32 s36, s36, s18
s_bfe_u32 s18, s97, 0x10001
s_lshl_b32 s18, s18, 14
s_add_u32 s36, s36, s18
s_bfe_u32 s18, s97, 0x40002
s_lshl_b32 s18, s18, 17
s_add_u32 s36, s36, s18
v_mfma_f32_16x16x32_bf16 v[92:95], v[220:223], v[8:11], 0
v_mfma_f32_16x16x32_bf16 v[92:95], v[224:227], v[12:15], v[92:95]
v_mfma_f32_16x16x32_bf16 v[92:95], v[228:231], v[16:19], v[92:95]
v_mfma_f32_16x16x32_bf16 v[92:95], v[232:235], v[20:23], v[92:95]
v_dot2_f32_bf16 v114, v220, v220, 0
v_dot2_f32_bf16 v115, v221, v221, 0
v_dot2_f32_bf16 v114, v222, v222, v114
v_dot2_f32_bf16 v115, v223, v223, v115
v_dot2_f32_bf16 v114, v224, v224, v114
v_dot2_f32_bf16 v115, v225, v225, v115
v_dot2_f32_bf16 v114, v226, v226, v114
v_dot2_f32_bf16 v115, v227, v227, v115
v_dot2_f32_bf16 v114, v228, v228, v114
v_dot2_f32_bf16 v115, v229, v229, v115
v_dot2_f32_bf16 v114, v230, v230, v114
v_dot2_f32_bf16 v115, v231, v231, v115
v_dot2_f32_bf16 v114, v232, v232, v114
v_dot2_f32_bf16 v115, v233, v233, v115
v_dot2_f32_bf16 v114, v234, v234, v114
v_dot2_f32_bf16 v115, v235, v235, v115
s_nop 2
v_add_f32 v114, v114, v115
s_nop 1
v_mfma_f32_16x16x4_f32 v[96:99], v114, v116, v[100:103]
s_nop 9
v_fma_f32 v128, v92, s42, v96
v_fma_f32 v129, v93, s42, v97
v_fma_f32 v130, v94, s42, v98
v_fma_f32 v131, v95, s42, v99
v_exp_f32 v128, v128
v_exp_f32 v129, v129
v_exp_f32 v130, v130
v_exp_f32 v131, v131
v_add_f32 v128, s43, v128
v_add_f32 v129, s43, v129
v_add_f32 v130, s43, v130
v_add_f32 v131, s43, v131
v_cvt_pk_bf16_f32 v108, v128, v129
v_cvt_pk_bf16_f32 v109, v130, v131
ds_write_b64 v126, v[108:109]
v_add_u32 v126, 256, v126
v_mfma_f32_16x16x16_bf16 v[88:91], v[108:109], v[112:113], v[88:91]
s_add_u32 s79, s79, 1
s_sub_u32 s38, s38, 1
s_cmp_lg_u32 s38, 0
s_cbranch_scc1 L_kloop
s_memrealtime s[60:61]
s_cmp_lg_u32 s79, 10
s_cbranch_scc1 L_rl15
v_and_b32 v4, 7, v1
v_lshlrev_b32 v4, 3, v4
s_mov_b32 s86, 1310720
buffer_load_dwordx2 v[236:237], v4, s[44:47], s86 offen
L_rl15:
s_waitcnt vmcnt(12)
s_cmp_eq_u32 s58, 0
s_cbranch_scc1 L_km16
ds_read_b128 v[156:159], v122 offset:8192
ds_read_b128 v[160:163], v123 offset:8192
ds_read_b128 v[164:167], v124 offset:8192
ds_read_b128 v[168:171], v125 offset:8192
s_waitcnt lgkmcnt(0)
L_km16:
v_mfma_f32_16x16x32_bf16 v[92:95], v[156:159], v[8:11], 0
v_mfma_f32_16x16x32_bf16 v[92:95], v[160:163], v[12:15], v[92:95]
v_mfma_f32_16x16x32_bf16 v[92:95], v[164:167], v[16:19], v[92:95]
v_mfma_f32_16x16x32_bf16 v[92:95], v[168:171], v[20:23], v[92:95]
v_dot2_f32_bf16 v114, v156, v156, 0
v_dot2_f32_bf16 v115, v157, v157, 0
v_dot2_f32_bf16 v114, v158, v158, v114
v_dot2_f32_bf16 v115, v159, v159, v115
v_dot2_f32_bf16 v114, v160, v160, v114
v_dot2_f32_bf16 v115, v161, v161, v115
v_dot2_f32_bf16 v114, v162, v162, v114
v_dot2_f32_bf16 v115, v163, v163, v115
v_dot2_f32_bf16 v114, v164, v164, v114
v_dot2_f32_bf16 v115, v165, v165, v115
v_dot2_f32_bf16 v114, v166, v166, v114
v_dot2_f32_bf16 v115, v167, v167, v115
v_dot2_f32_bf16 v114, v168, v168, v114
v_dot2_f32_bf16 v115, v169, v169, v115
v_dot2_f32_bf16 v114, v170, v170, v114
v_dot2_f32_bf16 v115, v171, v171, v115
s_cmp_lg_u32 s57, 0
s_cbranch_scc1 L_big17
buffer_load_dwordx2 v[156:157], v3, s[24:27], s39 offen offset:0 nt
buffer_load_dwordx2 v[158:159], v3, s[24:27], s39 offen offset:8 nt
buffer_load_dwordx2 v[160:161], v3, s[24:27], s39 offen offset:1024 nt
buffer_load_dwordx2 v[162:163], v3, s[24:27], s39 offen offset:1032 nt
buffer_load_dwordx2 v[164:165], v3, s[24:27], s39 offen offset:2048 nt
buffer_load_dwordx2 v[166:167], v3, s[24:27], s39 offen offset:2056 nt
buffer_load_dwordx2 v[168:169], v3, s[24:27], s39 offen offset:3072 nt
buffer_load_dwordx2 v[170:171], v3, s[24:27], s39 offen offset:3080 nt
s_mov_b32 s58, 0
s_branch L_cj18
L_big17:
buffer_load_dwordx4 v[156:159], v3, s[24:27], s39 offen offset:0 nt
buffer_load_dwordx4 v[160:163], v3, s[24:27], s39 offen offset:1024 nt
buffer_load_dwordx4 v[164:167], v3, s[24:27], s39 offen offset:2048 nt
buffer_load_dwordx4 v[168:171], v3, s[24:27], s39 offen offset:3072 nt
s_mov_b32 s58, 1
s_sub_u32 s57, s57, 1
L_cj18:
s_add_u32 s98, s98, 1
s_mov_b32 s39, s96
s_bfe_u32 s18, s98, 0x10000
s_lshl_b32 s18, s18, 12
s_add_u32 s39, s39, s18
s_bfe_u32 s18, s98, 0x10001
s_lshl_b32 s18, s18, 14
s_add_u32 s39, s39, s18
s_bfe_u32 s18, s98, 0x40002
s_lshl_b32 s18, s18, 17
s_add_u32 s39, s39, s18
v_add_f32 v114, v114, v115
s_nop 1
v_mfma_f32_16x16x4_f32 v[96:99], v114, v116, v[100:103]
s_nop 9
v_fma_f32 v128, v92, s42, v96
v_fma_f32 v129, v93, s42, v97
v_fma_f32 v130, v94, s42, v98
v_fma_f32 v131, v95, s42, v99
v_exp_f32 v128, v128
v_exp_f32 v129, v129
v_exp_f32 v130, v130
v_exp_f32 v131, v131
v_add_f32 v128, s43, v128
v_add_f32 v129, s43, v129
v_add_f32 v130, s43, v130
v_add_f32 v131, s43, v131
v_cvt_pk_bf16_f32 v108, v128, v129
v_cvt_pk_bf16_f32 v109, v130, v131
ds_write_b64 v126, v[108:109]
v_add_u32 v126, 256, v126
v_mfma_f32_16x16x16_bf16 v[88:91], v[108:109], v[112:113], v[88:91]
s_cmp_eq_u32 s58, 0
s_cbranch_scc1 L_wa20
s_waitcnt vmcnt(12)
s_branch L_we19
L_wa20:
s_waitcnt vmcnt(16)
L_we19:
ds_read_b128 v[220:223], v122 offset:0
ds_read_b128 v[224:227], v123 offset:0
ds_read_b128 v[228:231], v124 offset:0
ds_read_b128 v[232:235], v125 offset:0
s_waitcnt lgkmcnt(0)
buffer_load_dwordx4 v[188:191], v3, s[24:27], s39 offen offset:0 nt
buffer_load_dwordx4 v[192:195], v3, s[24:27], s39 offen offset:1024 nt
buffer_load_dwordx4 v[196:199], v3, s[24:27], s39 offen offset:2048 nt
buffer_load_dwordx4 v[200:203], v3, s[24:27], s39 offen offset:3072 nt
s_add_u32 s98, s98, 1
s_mov_b32 s39, s96
s_bfe_u32 s18, s98, 0x10000
s_lshl_b32 s18, s18, 12
s_add_u32 s39, s39, s18
s_bfe_u32 s18, s98, 0x10001
s_lshl_b32 s18, s18, 14
s_add_u32 s39, s39, s18
s_bfe_u32 s18, s98, 0x40002
s_lshl_b32 s18, s18, 17
s_add_u32 s39, s39, s18
v_mfma_f32_16x16x32_bf16 v[92:95], v[220:223], v[8:11], 0
v_mfma_f32_16x16x32_bf16 v[92:95], v[224:227], v[12:15], v[92:95]
v_mfma_f32_16x16x32_bf16 v[92:95], v[228:231], v[16:19], v[92:95]
v_mfma_f32_16x16x32_bf16 v[92:95], v[232:235], v[20:23], v[92:95]
v_dot2_f32_bf16 v114, v220, v220, 0
v_dot2_f32_bf16 v115, v221, v221, 0
v_dot2_f32_bf16 v114, v222, v222, v114
v_dot2_f32_bf16 v115, v223, v223, v115
v_dot2_f32_bf16 v114, v224, v224, v114
v_dot2_f32_bf16 v115, v225, v225, v115
v_dot2_f32_bf16 v114, v226, v226, v114
v_dot2_f32_bf16 v115, v227, v227, v115
v_dot2_f32_bf16 v114, v228, v228, v114
v_dot2_f32_bf16 v115, v229, v229, v115
v_dot2_f32_bf16 v114, v230, v230, v114
v_dot2_f32_bf16 v115, v231, v231, v115
v_dot2_f32_bf16 v114, v232, v232, v114
v_dot2_f32_bf16 v115, v233, v233, v115
v_dot2_f32_bf16 v114, v234, v234, v114
v_dot2_f32_bf16 v115, v235, v235, v115
s_nop 2
v_add_f32 v114, v114, v115
s_nop 1
v_mfma_f32_16x16x4_f32 v[96:99], v114, v116, v[100:103]
s_nop 9
v_fma_f32 v128, v92, s42, v96
v_fma_f32 v129, v93, s42, v97
v_fma_f32 v130, v94, s42, v98
v_fma_f32 v131, v95, s42, v99
v_exp_f32 v128, v128
v_exp_f32 v129, v129
v_exp_f32 v130, v130
v_exp_f32 v131, v131
v_add_f32 v128, s43, v128
v_add_f32 v129, s43, v129
v_add_f32 v130, s43, v130
v_add_f32 v131, s43, v131
v_cvt_pk_bf16_f32 v108, v128, v129
v_cvt_pk_bf16_f32 v109, v130, v131
ds_write_b64 v126, v[108:109]
v_add_u32 v126, 256, v126
v_mfma_f32_16x16x16_bf16 v[88:91], v[108:109], v[112:113], v[88:91]
s_mov_b32 s57, 0
s_cmp_eq_u32 s55, 0
s_cbranch_scc1 L_sp21
s_sub_u32 s60, s60, s55
s_sub_u32 s60, s60, s84
s_cmp_lg_u32 s79, 8
s_cbranch_scc1 L_rp22
s_cmp_lg_u32 s37, 0
s_cbranch_scc1 L_rp22
s_mul_i32 s61, s2, 1986
s_lshr_b32 s61, s61, 16
s_mul_i32 s85, s61, 33
s_cmp_lg_u32 s85, s2
s_cbranch_scc1 L_rp22
s_add_u32 s85, s60, 1048576
s_xor_b32 s86, s85, s55
v_mov_b32 v236, s85
v_mov_b32 v237, s86
s_lshl_b32 s61, s61, 3
v_mov_b32 v4, s61
s_mov_b32 s86, 1310720
s_mov_b64 exec, 1
buffer_store_dwordx2 v[236:237], v4, s[44:47], s86 offen sc1
s_mov_b64 exec, -1
L_rp22:
s_cmp_lg_u32 s79, 11
s_cbranch_scc1 L_rc23
s_mov_b32 s85, 0
s_mov_b32 s86, 0
v_readlane_b32 s61, v236, 0
v_readlane_b32 s94, v237, 0
s_nop 0
s_xor_b32 s94, s94, s61
s_cmp_eq_u32 s94, s55
s_cselect_b32 s61, s61, 0
s_cselect_b32 s94, 1, 0
s_add_u32 s85, s85, s61
s_add_u32 s86, s86, s94
v_readlane_b32 s61, v236, 1
v_readlane_b32 s94, v237, 1
s_nop 0
s_xor_b32 s94, s94, s61
s_cmp_eq_u32 s94, s55
s_cselect_b32 s61, s61, 0
s_cselect_b32 s94, 1, 0
s_add_u32 s85, s85, s61
s_add_u32 s86, s86, s94
v_readlane_b32 s61, v236, 2
v_readlane_b32 s94, v237, 2
s_nop 0
s_xor_b32 s94, s94, s61
s_cmp_eq_u32 s94, s55
s_cselect_b32 s61, s61, 0
s_cselect_b32 s94, 1, 0
s_add_u32 s85, s85, s61
s_add_u32 s86, s86, s94
v_readlane_b32 s61, v236, 3
v_readlane_b32 s94, v237, 3
s_nop 0
s_xor_b32 s94, s94, s61
s_cmp_eq_u32 s94, s55
s_cselect_b32 s61, s61, 0
s_cselect_b32 s94, 1, 0
s_add_u32 s85, s85, s61
s_add_u32 s86, s86, s94
v_readlane_b32 s61, v236, 4
v_readlane_b32 s94, v237, 4
s_nop 0
s_xor_b32 s94, s94, s61
s_cmp_eq_u32 s94, s55
s_cselect_b32 s61, s61, 0
s_cselect_b32 s94, 1, 0
s_add_u32 s85, s85, s61
s_add_u32 s86, s86, s94
v_readlane_b32 s61, v236, 5
v_readlane_b32 s94, v237, 5
s_nop 0
s_xor_b32 s94, s94, s61
s_cmp_eq_u32 s94, s55
s_cselect_b32 s61, s61, 0
s_cselect_b32 s94, 1, 0
s_add_u32 s85, s85, s61
s_add_u32 s86, s86, s94
v_readlane_b32 s61, v236, 6
v_readlane_b32 s94, v237, 6
s_nop 0
s_xor_b32 s94, s94, s61
s_cmp_eq_u32 s94, s55
s_cselect_b32 s61, s61, 0
s_cselect_b32 s94, 1, 0
s_add_u32 s85, s85, s61
s_add_u32 s86, s86, s94
v_readlane_b32 s61, v236, 7
v_readlane_b32 s94, v237, 7
s_nop 0
s_xor_b32 s94, s94, s61
s_cmp_eq_u32 s94, s55
s_cselect_b32 s61, s61, 0
s_cselect_b32 s94, 1, 0
s_add_u32 s85, s85, s61
s_add_u32 s86, s86, s94
s_cmp_lt_u32 s86, 8
s_cbranch_scc1 L_rc23
s_lshr_b32 s85, s85, 3
s_sub_u32 s85, s85, 1048576
s_add_u32 s84, s84, s85
s_sub_u32 s60, s60, s85
L_rc23:
s_cmp_gt_i32 s60, 100
s_cselect_b32 s57, 2, 0
s_min_u32 s57, s57, s93
s_sub_u32 s93, s93, s57
L_sp21:
s_cmp_ge_u32 s79, 28
s_cselect_b32 s57, 2, s57
s_add_u32 s84, s84, 215
s_cmp_eq_u32 s58, 0
s_cbranch_scc1 L_wa25
s_waitcnt vmcnt(12)
s_branch L_we24
L_wa25:
s_waitcnt vmcnt(16)
L_we24:
s_cmp_eq_u32 s59, 0
s_cbranch_scc1 L_km26
ds_read_b128 v[172:175], v122 offset:12288
ds_read_b128 v[176:179], v123 offset:12288
ds_read_b128 v[180:183], v124 offset:12288
ds_read_b128 v[184:187], v125 offset:12288
s_waitcnt lgkmcnt(0)
L_km26:
v_mfma_f32_16x16x32_bf16 v[92:95], v[172:175], v[8:11], 0
v_mfma_f32_16x16x32_bf16 v[92:95], v[176:179], v[12:15], v[92:95]
v_mfma_f32_16x16x32_bf16 v[92:95], v[180:183], v[16:19], v[92:95]
v_mfma_f32_16x16x32_bf16 v[92:95], v[184:187], v[20:23], v[92:95]
v_dot2_f32_bf16 v114, v172, v172, 0
v_dot2_f32_bf16 v115, v173, v173, 0
v_dot2_f32_bf16 v114, v174, v174, v114
v_dot2_f32_bf16 v115, v175, v175, v115
v_dot2_f32_bf16 v114, v176, v176, v114
v_dot2_f32_bf16 v115, v177, v177, v115
v_dot2_f32_bf16 v114, v178, v178, v114
v_dot2_f32_bf16 v115, v179, v179, v115
v_dot2_f32_bf16 v114, v180, v180, v114
v_dot2_f32_bf16 v115, v181, v181, v115
v_dot2_f32_bf16 v114, v182, v182, v114
v_dot2_f32_bf16 v115, v183, v183, v115
v_dot2_f32_bf16 v114, v184, v184, v114
v_dot2_f32_bf16 v115, v185, v185, v115
v_dot2_f32_bf16 v114, v186, v186, v114
v_dot2_f32_bf16 v115, v187, v187, v115
s_cmp_lg_u32 s57, 0
s_cbranch_scc1 L_big27
buffer_load_dwordx2 v[172:173], v3, s[24:27], s39 offen offset:0 nt
buffer_load_dwordx2 v[174:175], v3, s[24:27], s39 offen offset:8 nt
buffer_load_dwordx2 v[176:177], v3, s[24:27], s39 offen offset:1024 nt
buffer_load_dwordx2 v[178:179], v3, s[24:27], s39 offen offset:1032 nt
buffer_load_dwordx2 v[180:181], v3, s[24:27], s39 offen offset:2048 nt
buffer_load_dwordx2 v[182:183], v3, s[24:27], s39 offen offset:2056 nt
buffer_load_dwordx2 v[184:185], v3, s[24:27], s39 offen offset:3072 nt
buffer_load_dwordx2 v[186:187], v3, s[24:27], s39 offen offset:3080 nt
s_mov_b32 s59, 0
s_branch L_cj28
L_big27:
buffer_load_dwordx4 v[172:175], v3, s[24:27], s39 offen offset:0 nt
buffer_load_dwordx4 v[176:179], v3, s[24:27], s39 offen offset:1024 nt
buffer_load_dwordx4 v[180:183], v3, s[24:27], s39 offen offset:2048 nt
buffer_load_dwordx4 v[184:187], v3, s[24:27], s39 offen offset:3072 nt
s_mov_b32 s59, 1
s_sub_u32 s57, s57, 1
L_cj28:
s_add_u32 s98, s98, 1
s_mov_b32 s39, s96
s_bfe_u32 s18, s98, 0x10000
s_lshl_b32 s18, s18, 12
s_add_u32 s39, s39, s18
s_bfe_u32 s18, s98, 0x10001
s_lshl_b32 s18, s18, 14
s_add_u32 s39, s39, s18
s_bfe_u32 s18, s98, 0x40002
s_lshl_b32 s18, s18, 17
s_add_u32 s39, s39, s18
v_add_f32 v114, v114, v115
s_nop 1
v_mfma_f32_16x16x4_f32 v[96:99], v114, v116, v[100:103]
s_nop 9
v_fma_f32 v128, v92, s42, v96
v_fma_f32 v129, v93, s42, v97
v_fma_f32 v130, v94, s42, v98
v_fma_f32 v131, v95, s42, v99
v_exp_f32 v128, v128
v_exp_f32 v129, v129
v_exp_f32 v130, v130
v_exp_f32 v131, v131
v_add_f32 v128, s43, v128
v_add_f32 v129, s43, v129
v_add_f32 v130, s43, v130
v_add_f32 v131, s43, v131
v_cvt_pk_bf16_f32 v108, v128, v129
v_cvt_pk_bf16_f32 v109, v130, v131
ds_write_b64 v126, v[108:109]
v_add_u32 v126, 256, v126
v_mfma_f32_16x16x16_bf16 v[88:91], v[108:109], v[112:113], v[88:91]
s_add_u32 s85, s58, s59
s_cmp_eq_u32 s85, 0
s_cbranch_scc1 L_wa30
s_cmp_eq_u32 s85, 1
s_cbranch_scc1 L_wb31
s_waitcnt vmcnt(12)
s_branch L_we29
L_wb31:
s_waitcnt vmcnt(16)
s_branch L_we29
L_wa30:
s_waitcnt vmcnt(20)
L_we29:
ds_read_b128 v[220:223], v122 offset:4096
ds_read_b128 v[224:227], v123 offset:4096
ds_read_b128 v[228:231], v124 offset:4096
ds_read_b128 v[232:235], v125 offset:4096
s_waitcnt lgkmcnt(0)
buffer_load_dwordx4 v[204:207], v3, s[24:27], s39 offen offset:0 nt
buffer_load_dwordx4 v[208:211], v3, s[24:27], s39 offen offset:1024 nt
buffer_load_dwordx4 v[212:215], v3, s[24:27], s39 offen offset:2048 nt
buffer_load_dwordx4 v[216:219], v3, s[24:27], s39 offen offset:3072 nt
s_add_u32 s98, s98, 1
s_mov_b32 s39, s96
s_bfe_u32 s18, s98, 0x10000
s_lshl_b32 s18, s18, 12
s_add_u32 s39, s39, s18
s_bfe_u32 s18, s98, 0x10001
s_lshl_b32 s18, s18, 14
s_add_u32 s39, s39, s18
s_bfe_u32 s18, s98, 0x40002
s_lshl_b32 s18, s18, 17
s_add_u32 s39, s39, s18
v_mfma_f32_16x16x32_bf16 v[92:95], v[220:223], v[8:11], 0
v_mfma_f32_16x16x32_bf16 v[92:95], v[224:227], v[12:15], v[92:95]
v_mfma_f32_16x16x32_bf16 v[92:95], v[228:231], v[16:19], v[92:95]
v_mfma_f32_16x16x32_bf16 v[92:95], v[232:235], v[20:23], v[92:95]
v_dot2_f32_bf16 v114, v220, v220, 0
v_dot2_f32_bf16 v115, v221, v221, 0
v_dot2_f32_bf16 v114, v222, v222, v114
v_dot2_f32_bf16 v115, v223, v223, v115
v_dot2_f32_bf16 v114, v224, v224, v114
v_dot2_f32_bf16 v115, v225, v225, v115
v_dot2_f32_bf16 v114, v226, v226, v114
v_dot2_f32_bf16 v115, v227, v227, v115
v_dot2_f32_bf16 v114, v228, v228, v114
v_dot2_f32_bf16 v115, v229, v229, v115
v_dot2_f32_bf16 v114, v230, v230, v114
v_dot2_f32_bf16 v115, v231, v231, v115
v_dot2_f32_bf16 v114, v232, v232, v114
v_dot2_f32_bf16 v115, v233, v233, v115
v_dot2_f32_bf16 v114, v234, v234, v114
v_dot2_f32_bf16 v115, v235, v235, v115
s_nop 2
v_add_f32 v114, v114, v115
s_nop 1
v_mfma_f32_16x16x4_f32 v[96:99], v114, v116, v[100:103]
s_nop 9
v_fma_f32 v128, v92, s42, v96
v_fma_f32 v129, v93, s42, v97
v_fma_f32 v130, v94, s42, v98
v_fma_f32 v131, v95, s42, v99
v_exp_f32 v128, v128
v_exp_f32 v129, v129
v_exp_f32 v130, v130
v_exp_f32 v131, v131
v_add_f32 v128, s43, v128
v_add_f32 v129, s43, v129
v_add_f32 v130, s43, v130
v_add_f32 v131, s43, v131
v_cvt_pk_bf16_f32 v108, v128, v129
v_cvt_pk_bf16_f32 v109, v130, v131
ds_write_b64 v126, v[108:109]
v_add_u32 v126, 256, v126
v_mfma_f32_16x16x16_bf16 v[88:91], v[108:109], v[112:113], v[88:91]
s_add_u32 s79, s79, 1
ds_read_b64 v[108:109], v127
v_add_u32 v127, 256, v127
s_mov_b32 s38, 15
L_vloop:
s_memrealtime s[60:61]
s_cmp_eq_u32 s59, 0
s_cbranch_scc1 L_wa35
s_waitcnt vmcnt(12)
s_branch L_we34
L_wa35:
s_waitcnt vmcnt(16)
L_we34:
v_perm_b32 v132, v160, v156, s40
v_perm_b32 v133, v168, v164, s40
v_perm_b32 v134, v160, v156, s41
v_perm_b32 v135, v168, v164, s41
v_perm_b32 v136, v161, v157, s40
v_perm_b32 v137, v169, v165, s40
v_perm_b32 v138, v161, v157, s41
v_perm_b32 v139, v169, v165, s41
v_perm_b32 v140, v162, v158, s40
v_perm_b32 v141, v170, v166, s40
v_perm_b32 v142, v162, v158, s41
v_perm_b32 v143, v170, v166, s41
v_perm_b32 v144, v163, v159, s40
v_perm_b32 v145, v171, v167, s40
v_perm_b32 v146, v163, v159, s41
v_perm_b32 v147, v171, v167, s41
s_cmp_lg_u32 s57, 0
s_cbranch_scc1 L_big36
buffer_load_dwordx2 v[156:157], v3, s[24:27], s39 offen offset:0 nt
buffer_load_dwordx2 v[158:159], v3, s[24:27], s39 offen offset:8 nt
buffer_load_dwordx2 v[160:161], v3, s[24:27], s39 offen offset:1024 nt
buffer_load_dwordx2 v[162:163], v3, s[24:27], s39 offen offset:1032 nt
buffer_load_dwordx2 v[164:165], v3, s[24:27], s39 offen offset:2048 nt
buffer_load_dwordx2 v[166:167], v3, s[24:27], s39 offen offset:2056 nt
buffer_load_dwordx2 v[168:169], v3, s[24:27], s39 offen offset:3072 nt
buffer_load_dwordx2 v[170:171], v3, s[24:27], s39 offen offset:3080 nt
s_mov_b32 s58, 0
s_branch L_cj37
L_big36:
buffer_load_dwordx4 v[156:159], v3, s[24:27], s39 offen offset:0 nt
buffer_load_dwordx4 v[160:163], v3, s[24:27], s39 offen offset:1024 nt
buffer_load_dwordx4 v[164:167], v3, s[24:27], s39 offen offset:2048 nt
buffer_load_dwordx4 v[168:171], v3, s[24:27], s39 offen offset:3072 nt
s_mov_b32 s58, 1
s_sub_u32 s57, s57, 1
L_cj37:
s_add_u32 s98, s98, 1
s_mov_b32 s39, s96
s_bfe_u32 s18, s98, 0x10000
s_lshl_b32 s18, s18, 12
s_add_u32 s39, s39, s18
s_bfe_u32 s18, s98, 0x10001
s_lshl_b32 s18, s18, 14
s_add_u32 s39, s39, s18
s_bfe_u32 s18, s98, 0x40002
s_lshl_b32 s18, s18, 17
s_add_u32 s39, s39, s18
s_waitcnt lgkmcnt(0)
v_mfma_f32_16x16x16_bf16 v[24:27], v[108:109], v[132:133], v[24:27]
v_mfma_f32_16x16x16_bf16 v[28:31], v[108:109], v[134:135], v[28:31]
v_mfma_f32_16x16x16_bf16 v[32:35], v[108:109], v[136:137], v[32:35]
v_mfma_f32_16x16x16_bf16 v[36:39], v[108:109], v[138:139], v[36:39]
v_mfma_f32_16x16x16_bf16 v[40:43], v[108:109], v[140:141], v[40:43]
v_mfma_f32_16x16x16_bf16 v[44:47], v[108:109], v[142:143], v[44:47]
v_mfma_f32_16x16x16_bf16 v[48:51], v[108:109], v[144:145], v[48:51]
v_mfma_f32_16x16x16_bf16 v[52:55], v[108:109], v[146:147], v[52:55]
ds_read_b64 v[110:111], v127
v_add_u32 v127, 256, v127
s_add_u32 s85, s58, s59
s_cmp_eq_u32 s85, 0
s_cbranch_scc1 L_wa39
s_cmp_eq_u32 s85, 1
s_cbranch_scc1 L_wb40
s_waitcnt vmcnt(12)
s_branch L_we38
L_wb40:
s_waitcnt vmcnt(16)
s_branch L_we38
L_wa39:
s_waitcnt vmcnt(20)
L_we38:
v_perm_b32 v132, v192, v188, s40
v_perm_b32 v133, v200, v196, s40
v_perm_b32 v134, v192, v188, s41
v_perm_b32 v135, v200, v196, s41
v_perm_b32 v136, v193, v189, s40
v_perm_b32 v137, v201, v197, s40
v_perm_b32 v138, v193, v189, s41
v_perm_b32 v139, v201, v197, s41
v_perm_b32 v140, v194, v190, s40
v_perm_b32 v141, v202, v198, s40
v_perm_b32 v142, v194, v190, s41
v_perm_b32 v143, v202, v198, s41
v_perm_b32 v144, v195, v191, s40
v_perm_b32 v145, v203, v199, s40
v_perm_b32 v146, v195, v191, s41
v_perm_b32 v147, v203, v199, s41
buffer_load_dwordx4 v[188:191], v3, s[24:27], s39 offen offset:0 nt
buffer_load_dwordx4 v[192:195], v3, s[24:27], s39 offen offset:1024 nt
buffer_load_dwordx4 v[196:199], v3, s[24:27], s39 offen offset:2048 nt
buffer_load_dwordx4 v[200:203], v3, s[24:27], s39 offen offset:3072 nt
s_add_u32 s98, s98, 1
s_mov_b32 s39, s96
s_bfe_u32 s18, s98, 0x10000
s_lshl_b32 s18, s18, 12
s_add_u32 s39, s39, s18
s_bfe_u32 s18, s98, 0x10001
s_lshl_b32 s18, s18, 14
s_add_u32 s39, s39, s18
s_bfe_u32 s18, s98, 0x40002
s_lshl_b32 s18, s18, 17
s_add_u32 s39, s39, s18
s_waitcnt lgkmcnt(0)
v_mfma_f32_16x16x16_bf16 v[24:27], v[110:111], v[132:133], v[24:27]
v_mfma_f32_16x16x16_bf16 v[28:31], v[110:111], v[134:135], v[28:31]
v_mfma_f32_16x16x16_bf16 v[32:35], v[110:111], v[136:137], v[32:35]
v_mfma_f32_16x16x16_bf16 v[36:39], v[110:111], v[138:139], v[36:39]
v_mfma_f32_16x16x16_bf16 v[40:43], v[110:111], v[140:141], v[40:43]
v_mfma_f32_16x16x16_bf16 v[44:47], v[110:111], v[142:143], v[44:47]
v_mfma_f32_16x16x16_bf16 v[48:51], v[110:111], v[144:145], v[48:51]
v_mfma_f32_16x16x16_bf16 v[52:55], v[110:111], v[146:147], v[52:55]
ds_read_b64 v[108:109], v127
v_add_u32 v127, 256, v127
s_mov_b32 s57, 0
s_cmp_eq_u32 s55, 0
s_cbranch_scc1 L_sp41
s_sub_u32 s60, s60, s55
s_sub_u32 s60, s60, s84
s_cmp_gt_i32 s60, 100
s_cselect_b32 s57, 2, 0
s_min_u32 s57, s57, s93
s_sub_u32 s93, s93, s57
s_cmp_lt_u32 s79, 28
s_cbranch_scc1 L_ss42
s_cmp_gt_i32 s60, 0
s_cselect_b32 s57, 2, s57
L_ss42:
L_sp41:
s_add_u32 s84, s84, 218
s_cmp_eq_u32 s58, 0
s_cbranch_scc1 L_wa44
s_waitcnt vmcnt(12)
s_branch L_we43
L_wa44:
s_waitcnt vmcnt(16)
L_we43:
v_perm_b32 v132, v176, v172, s40
v_perm_b32 v133, v184, v180, s40
v_perm_b32 v134, v176, v172, s41
v_perm_b32 v135, v184, v180, s41
v_perm_b32 v136, v177, v173, s40
v_perm_b32 v137, v185, v181, s40
v_perm_b32 v138, v177, v173, s41
v_perm_b32 v139, v185, v181, s41
v_perm_b32 v140, v178, v174, s40
v_perm_b32 v141, v186, v182, s40
v_perm_b32 v142, v178, v174, s41
v_perm_b32 v143, v186, v182, s41
v_perm_b32 v144, v179, v175, s40
v_perm_b32 v145, v187, v183, s40
v_perm_b32 v146, v179, v175, s41
v_perm_b32 v147, v187, v183, s41
s_cmp_lg_u32 s57, 0
s_cbranch_scc1 L_big45
buffer_load_dwordx2 v[172:173], v3, s[24:27], s39 offen offset:0 nt
buffer_load_dwordx2 v[174:175], v3, s[24:27], s39 offen offset:8 nt
buffer_load_dwordx2 v[176:177], v3, s[24:27], s39 offen offset:1024 nt
buffer_load_dwordx2 v[178:179], v3, s[24:27], s39 offen offset:1032 nt
buffer_load_dwordx2 v[180:181], v3, s[24:27], s39 offen offset:2048 nt
buffer_load_dwordx2 v[182:183], v3, s[24:27], s39 offen offset:2056 nt
buffer_load_dwordx2 v[184:185], v3, s[24:27], s39 offen offset:3072 nt
buffer_load_dwordx2 v[186:187], v3, s[24:27], s39 offen offset:3080 nt
s_mov_b32 s59, 0
s_branch L_cj46
L_big45:
buffer_load_dwordx4 v[172:175], v3, s[24:27], s39 offen offset:0 nt
buffer_load_dwordx4 v[176:179], v3, s[24:27], s39 offen offset:1024 nt
buffer_load_dwordx4 v[180:183], v3, s[24:27], s39 offen offset:2048 nt
buffer_load_dwordx4 v[184:187], v3, s[24:27], s39 offen offset:3072 nt
s_mov_b32 s59, 1
s_sub_u32 s57, s57, 1
L_cj46:
s_add_u32 s98, s98, 1
s_mov_b32 s39, s96
s_bfe_u32 s18, s98, 0x10000
s_lshl_b32 s18, s18, 12
s_add_u32 s39, s39, s18
s_bfe_u32 s18, s98, 0x10001
s_lshl_b32 s18, s18, 14
s_add_u32 s39, s39, s18
s_bfe_u32 s18, s98, 0x40002
s_lshl_b32 s18, s18, 17
s_add_u32 s39, s39, s18
s_waitcnt lgkmcnt(0)
v_mfma_f32_16x16x16_bf16 v[24:27], v[108:109], v[132:133], v[24:27]
v_mfma_f32_16x16x16_bf16 v[28:31], v[108:109], v[134:135], v[28:31]
v_mfma_f32_16x16x16_bf16 v[32:35], v[108:109], v[136:137], v[32:35]
v_mfma_f32_16x16x16_bf16 v[36:39], v[108:109], v[138:139], v[36:39]
v_mfma_f32_16x16x16_bf16 v[40:43], v[108:109], v[140:141], v[40:43]
v_mfma_f32_16x16x16_bf16 v[44:47], v[108:109], v[142:143], v[44:47]
v_mfma_f32_16x16x16_bf16 v[48:51], v[108:109], v[144:145], v[48:51]
v_mfma_f32_16x16x16_bf16 v[52:55], v[108:109], v[146:147], v[52:55]
ds_read_b64 v[110:111], v127
v_add_u32 v127, 256, v127
s_add_u32 s85, s58, s59
s_cmp_eq_u32 s85, 0
s_cbranch_scc1 L_wa48
s_cmp_eq_u32 s85, 1
s_cbranch_scc1 L_wb49
s_waitcnt vmcnt(12)
s_branch L_we47
L_wb49:
s_waitcnt vmcnt(16)
s_branch L_we47
L_wa48:
s_waitcnt vmcnt(20)
L_we47:
v_perm_b32 v132, v208, v204, s40
v_perm_b32 v133, v216, v212, s40
v_perm_b32 v134, v208, v204, s41
v_perm_b32 v135, v216, v212, s41
v_perm_b32 v136, v209, v205, s40
v_perm_b32 v137, v217, v213, s40
v_perm_b32 v138, v209, v205, s41
v_perm_b32 v139, v217, v213, s41
v_perm_b32 v140, v210, v206, s40
v_perm_b32 v141, v218, v214, s40
v_perm_b32 v142, v210, v206, s41
v_perm_b32 v143, v218, v214, s41
v_perm_b32 v144, v211, v207, s40
v_perm_b32 v145, v219, v215, s40
v_perm_b32 v146, v211, v207, s41
v_perm_b32 v147, v219, v215, s41
buffer_load_dwordx4 v[204:207], v3, s[24:27], s39 offen offset:0 nt
buffer_load_dwordx4 v[208:211], v3, s[24:27], s39 offen offset:1024 nt
buffer_load_dwordx4 v[212:215], v3, s[24:27], s39 offen offset:2048 nt
buffer_load_dwordx4 v[216:219], v3, s[24:27], s39 offen offset:3072 nt
s_add_u32 s98, s98, 1
s_mov_b32 s39, s96
s_bfe_u32 s18, s98, 0x10000
s_lshl_b32 s18, s18, 12
s_add_u32 s39, s39, s18
s_bfe_u32 s18, s98, 0x10001
s_lshl_b32 s18, s18, 14
s_add_u32 s39, s39, s18
s_bfe_u32 s18, s98, 0x40002
s_lshl_b32 s18, s18, 17
s_add_u32 s39, s39, s18
s_waitcnt lgkmcnt(0)
v_mfma_f32_16x16x16_bf16 v[24:27], v[110:111], v[132:133], v[24:27]
v_mfma_f32_16x16x16_bf16 v[28:31], v[110:111], v[134:135], v[28:31]
v_mfma_f32_16x16x16_bf16 v[32:35], v[110:111], v[136:137], v[32:35]
v_mfma_f32_16x16x16_bf16 v[36:39], v[110:111], v[138:139], v[36:39]
v_mfma_f32_16x16x16_bf16 v[40:43], v[110:111], v[140:141], v[40:43]
v_mfma_f32_16x16x16_bf16 v[44:47], v[110:111], v[142:143], v[44:47]
v_mfma_f32_16x16x16_bf16 v[48:51], v[110:111], v[144:145], v[48:51]
v_mfma_f32_16x16x16_bf16 v[52:55], v[110:111], v[146:147], v[52:55]
ds_read_b64 v[108:109], v127
v_add_u32 v127, 256, v127
s_add_u32 s79, s79, 1
s_sub_u32 s38, s38, 1
s_cmp_lg_u32 s38, 0
s_cbranch_scc1 L_vloop
v_lshlrev_b32 v6, 5, v1
v_add_u32 v6, s53, v6
v_lshrrev_b32 v7, 4, v1
v_lshlrev_b32 v7, 9, v7
v_and_b32 v5, 15, v1
v_lshl_add_u32 v7, v5, 3, v7
v_add_u32 v7, s53, v7
s_cmp_eq_u32 s59, 0
s_cbranch_scc1 L_wa51
s_waitcnt vmcnt(12)
s_branch L_we50
L_wa51:
s_waitcnt vmcnt(16)
L_we50:
s_cmp_lg_u32 s37, 0
s_cbranch_scc1 L_w0_1
v_mov_b32 v4, 0
buffer_load_dword v152, v4, s[48:51], 0 offen
L_w0_1:
s_waitcnt lgkmcnt(0)
v_perm_b32 v132, v160, v156, s40
v_perm_b32 v133, v168, v164, s40
v_perm_b32 v134, v160, v156, s41
v_perm_b32 v135, v168, v164, s41
v_perm_b32 v136, v161, v157, s40
v_perm_b32 v137, v169, v165, s40
v_perm_b32 v138, v161, v157, s41
v_perm_b32 v139, v169, v165, s41
v_mfma_f32_16x16x16_bf16 v[24:27], v[108:109], v[132:133], v[24:27]
v_mfma_f32_16x16x16_bf16 v[28:31], v[108:109], v[134:135], v[28:31]
v_perm_b32 v140, v162, v158, s40
v_perm_b32 v141, v170, v166, s40
v_perm_b32 v142, v162, v158, s41
v_perm_b32 v143, v170, v166, s41
v_mfma_f32_16x16x16_bf16 v[32:35], v[108:109], v[136:137], v[32:35]
v_mfma_f32_16x16x16_bf16 v[36:39], v[108:109], v[138:139], v[36:39]
v_perm_b32 v144, v163, v159, s40
v_perm_b32 v145, v171, v167, s40
v_perm_b32 v146, v163, v159, s41
v_perm_b32 v147, v171, v167, s41
v_mfma_f32_16x16x16_bf16 v[40:43], v[108:109], v[140:141], v[40:43]
v_mfma_f32_16x16x16_bf16 v[44:47], v[108:109], v[142:143], v[44:47]
v_mfma_f32_16x16x16_bf16 v[48:51], v[108:109], v[144:145], v[48:51]
v_mfma_f32_16x16x16_bf16 v[52:55], v[108:109], v[146:147], v[52:55]
ds_read_b64 v[110:111], v127
v_add_u32 v127, 256, v127
s_cmp_eq_u32 s59, 0
s_cbranch_scc1 L_wa53
s_waitcnt vmcnt(8)
s_branch L_we52
L_wa53:
s_waitcnt vmcnt(12)
L_we52:
s_waitcnt lgkmcnt(0)
v_perm_b32 v132, v192, v188, s40
v_perm_b32 v133, v200, v196, s40
v_perm_b32 v134, v192, v188, s41
v_perm_b32 v135, v200, v196, s41
v_perm_b32 v136, v193, v189, s40
v_perm_b32 v137, v201, v197, s40
v_perm_b32 v138, v193, v189, s41
v_perm_b32 v139, v201, v197, s41
v_mfma_f32_16x16x16_bf16 v[24:27], v[110:111], v[132:133], v[24:27]
v_mfma_f32_16x16x16_bf16 v[28:31], v[110:111], v[134:135], v[28:31]
v_perm_b32 v140, v194, v190, s40
v_perm_b32 v141, v202, v198, s40
v_perm_b32 v142, v194, v190, s41
v_perm_b32 v143, v202, v198, s41
v_mfma_f32_16x16x16_bf16 v[32:35], v[110:111], v[136:137], v[32:35]
v_mfma_f32_16x16x16_bf16 v[36:39], v[110:111], v[138:139], v[36:39]
v_perm_b32 v144, v195, v191, s40
v_perm_b32 v145, v203, v199, s40
v_perm_b32 v146, v195, v191, s41
v_perm_b32 v147, v203, v199, s41
v_mfma_f32_16x16x16_bf16 v[40:43], v[110:111], v[140:141], v[40:43]
v_mfma_f32_16x16x16_bf16 v[44:47], v[110:111], v[142:143], v[44:47]
v_mfma_f32_16x16x16_bf16 v[48:51], v[110:111], v[144:145], v[48:51]
v_mfma_f32_16x16x16_bf16 v[52:55], v[110:111], v[146:147], v[52:55]
ds_read_b64 v[108:109], v127
v_add_u32 v127, 256, v127
s_waitcnt vmcnt(4)
s_waitcnt lgkmcnt(0)
v_perm_b32 v132, v176, v172, s40
v_perm_b32 v133, v184, v180, s40
v_perm_b32 v134, v176, v172, s41
v_perm_b32 v135, v184, v180, s41
v_perm_b32 v136, v177, v173, s40
v_perm_b32 v137, v185, v181, s40
v_perm_b32 v138, v177, v173, s41
v_perm_b32 v139, v185, v181, s41
v_mfma_f32_16x16x16_bf16 v[24:27], v[108:109], v[132:133], v[24:27]
v_mfma_f32_16x16x16_bf16 v[28:31], v[108:109], v[134:135], v[28:31]
v_perm_b32 v140, v178, v174, s40
v_perm_b32 v141, v186, v182, s40
v_perm_b32 v142, v178, v174, s41
v_perm_b32 v143, v186, v182, s41
v_mfma_f32_16x16x16_bf16 v[32:35], v[108:109], v[136:137], v[32:35]
v_mfma_f32_16x16x16_bf16 v[36:39], v[108:109], v[138:139], v[36:39]
v_perm_b32 v144, v179, v175, s40
v_perm_b32 v145, v187, v183, s40
v_perm_b32 v146, v179, v175, s41
v_perm_b32 v147, v187, v183, s41
v_mfma_f32_16x16x16_bf16 v[40:43], v[108:109], v[140:141], v[40:43]
v_mfma_f32_16x16x16_bf16 v[44:47], v[108:109], v[142:143], v[44:47]
v_mfma_f32_16x16x16_bf16 v[48:51], v[108:109], v[144:145], v[48:51]
v_mfma_f32_16x16x16_bf16 v[52:55], v[108:109], v[146:147], v[52:55]
ds_read_b64 v[110:111], v127
v_add_u32 v127, 256, v127
v_mul_f32 v128, v104, v88
v_fmac_f32 v128, v105, v89
v_fmac_f32 v128, v106, v90
v_fmac_f32 v128, v107, v91
v_lshlrev_b32 v5, 2, v1
v_add_u32 v5, s53, v5
s_mov_b32 exec_hi, 0
ds_write_b32 v5, v128 offset:2048
s_mov_b32 exec_hi, -1
s_cmp_lg_u32 s37, 0
s_cbranch_scc1 L_nolook
buffer_load_dwordx4 v[148:151], v3, s[44:47], s54 offen sc1
s_waitcnt vmcnt(1)
s_branch L_looked
L_nolook:
s_waitcnt vmcnt(0)
L_looked:
s_waitcnt lgkmcnt(0)
v_perm_b32 v132, v208, v204, s40
v_perm_b32 v133, v216, v212, s40
v_perm_b32 v134, v208, v204, s41
v_perm_b32 v135, v216, v212, s41
v_perm_b32 v136, v209, v205, s40
v_perm_b32 v137, v217, v213, s40
v_perm_b32 v138, v209, v205, s41
v_perm_b32 v139, v217, v213, s41
v_mfma_f32_16x16x16_bf16 v[24:27], v[110:111], v[132:133], v[24:27]
v_mfma_f32_16x16x16_bf16 v[28:31], v[110:111], v[134:135], v[28:31]
v_perm_b32 v140, v210, v206, s40
v_perm_b32 v141, v218, v214, s40
v_perm_b32 v142, v210, v206, s41
v_perm_b32 v143, v218, v214, s41
v_mfma_f32_16x16x16_bf16 v[32:35], v[110:111], v[136:137], v[32:35]
v_mfma_f32_16x16x16_bf16 v[36:39], v[110:111], v[138:139], v[36:39]
v_perm_b32 v144, v211, v207, s40
v_perm_b32 v145, v219, v215, s40
v_perm_b32 v146, v211, v207, s41
v_perm_b32 v147, v219, v215, s41
v_mfma_f32_16x16x16_bf16 v[40:43], v[110:111], v[140:141], v[40:43]
v_mfma_f32_16x16x16_bf16 v[44:47], v[110:111], v[142:143], v[44:47]
v_mfma_f32_16x16x16_bf16 v[48:51], v[110:111], v[144:145], v[48:51]
v_mfma_f32_16x16x16_bf16 v[52:55], v[110:111], v[146:147], v[52:55]
s_nop 0
v_mul_f32 v220, v104, v24
v_fmac_f32 v220, v105, v25
v_fmac_f32 v220, v106, v26
v_fmac_f32 v220, v107, v27
v_mul_f32 v221, v104, v28
v_fmac_f32 v221, v105, v29
v_fmac_f32 v221, v106, v30
v_fmac_f32 v221, v107, v31
v_mul_f32 v222, v104, v32
v_fmac_f32 v222, v105, v33
v_fmac_f32 v222, v106, v34
v_fmac_f32 v222, v107, v35
v_mul_f32 v223, v104, v36
v_fmac_f32 v223, v105, v37
v_fmac_f32 v223, v106, v38
v_fmac_f32 v223, v107, v39
v_mul_f32 v224, v104, v40
v_fmac_f32 v224, v105, v41
v_fmac_f32 v224, v106, v42
v_fmac_f32 v224, v107, v43
v_mul_f32 v225, v104, v44
v_fmac_f32 v225, v105, v45
v_fmac_f32 v225, v106, v46
v_fmac_f32 v225, v107, v47
v_mul_f32 v226, v104, v48
v_fmac_f32 v226, v105, v49
v_fmac_f32 v226, v106, v50
v_fmac_f32 v226, v107, v51
v_mul_f32 v227, v104, v52
v_fmac_f32 v227, v105, v53
v_fmac_f32 v227, v106, v54
v_fmac_f32 v227, v107, v55
s_mov_b32 exec_hi, 0
ds_write_b128 v6, v[220:223]
ds_write_b128 v6, v[224:227] offset:16
s_mov_b32 exec_hi, -1
s_waitcnt lgkmcnt(0)
s_barrier
s_cmp_lg_u32 s37, 0
s_cbranch_scc1 L_fin
v_lshlrev_b32 v4, 3, v1
v_add_u32 v4, 65536, v4
v_mov_b32 v5, 65536
ds_read_b64 v[24:25], v4 offset:0
ds_read_b64 v[26:27], v4 offset:512
ds_read_b64 v[28:29], v4 offset:16384
ds_read_b64 v[30:31], v4 offset:16896
ds_read_b64 v[32:33], v4 offset:32768
ds_read_b64 v[34:35], v4 offset:33280
ds_read_b64 v[36:37], v4 offset:49152
ds_read_b64 v[38:39], v4 offset:49664
ds_read_b32 v156, v5 offset:2048
ds_read_b32 v157, v5 offset:2112
ds_read_b32 v158, v5 offset:18432
ds_read_b32 v159, v5 offset:18496
ds_read_b32 v160, v5 offset:34816
ds_read_b32 v161, v5 offset:34880
ds_read_b32 v162, v5 offset:51200
ds_read_b32 v163, v5 offset:51264
s_mov_b32 s24, s12
s_mov_b32 s25, s13
s_mov_b32 s26, 32768
s_mov_b32 s27, 0x20000
s_waitcnt lgkmcnt(0)
v_add_f32 v24, v24, v26
v_add_f32 v25, v25, v27
v_add_f32 v28, v28, v30
v_add_f32 v29, v29, v31
v_add_f32 v32, v32, v34
v_add_f32 v33, v33, v35
v_add_f32 v36, v36, v38
v_add_f32 v37, v37, v39
v_add_f32 v24, v24, v28
v_add_f32 v25, v25, v29
v_add_f32 v32, v32, v36
v_add_f32 v33, v33, v37
v_add_f32 v24, v24, v32
v_add_f32 v25, v25, v33
v_add_f32 v156, v156, v157
v_add_f32 v158, v158, v159
v_add_f32 v160, v160, v161
v_add_f32 v162, v162, v163
v_add_f32 v156, v156, v158
v_add_f32 v160, v160, v162
v_add_f32 v156, v156, v160
v_mov_b32 v92, v24
v_mov_b32 v93, v25
v_mov_b32 v94, v156
s_waitcnt vmcnt(0)
v_readfirstlane_b32 s55, v152
s_nop 3
s_cmp_lg_u32 s55, 0
s_cbranch_scc1 L_havetag
s_memrealtime s[56:57]
s_waitcnt lgkmcnt(0)
s_or_b32 s56, s56, 1
v_mov_b32 v154, s56
v_mov_b32 v155, 0
v_mov_b32 v4, 0
s_mov_b64 exec, 1
buffer_atomic_cmpswap v[154:155], v4, s[48:51], 0 offen sc0
s_waitcnt vmcnt(0)
s_mov_b64 exec, -1
v_readfirstlane_b32 s55, v154
s_nop 3
s_cmp_eq_u32 s55, 0
s_cselect_b32 s55, s56, s55
L_havetag:
v_xor_b32 v4, v148, v149
v_xor_b32 v5, v150, v151
v_xor_b32 v4, v4, v5
v_cmp_eq_u32 vcc, s55, v4
s_nop 1
s_cmp_eq_u64 vcc, exec
s_cbranch_scc1 L_final
v_xor_b32 v4, v92, v93
v_xor_b32 v4, v4, v94
v_xor_b32 v95, s55, v4
buffer_store_dwordx4 v[92:95], v3, s[44:47], s52 offen sc1
buffer_load_dwordx4 v[148:151], v3, s[44:47], s54 offen sc1
s_waitcnt vmcnt(0)
v_xor_b32 v4, v148, v149
v_xor_b32 v5, v150, v151
v_xor_b32 v4, v4, v5
v_cmp_eq_u32 vcc, s55, v4
s_nop 1
s_cmp_eq_u64 vcc, exec
s_cbranch_scc1 L_final
buffer_load_dwordx4 v[148:151], v3, s[44:47], s54 offen sc1
s_waitcnt vmcnt(0)
v_xor_b32 v4, v148, v149
v_xor_b32 v5, v150, v151
v_xor_b32 v4, v4, v5
v_cmp_eq_u32 vcc, s55, v4
s_nop 1
s_cmp_eq_u64 vcc, exec
s_cbranch_scc0 L_fin
L_final:
v_add_f32 v92, v92, v148
v_add_f32 v93, v93, v149
v_add_f32 v94, v94, v150
v_add_f32 v94, s43, v94
v_rcp_f32 v94, v94
s_nop 0
v_mul_f32 v92, v92, v94
v_mul_f32 v93, v93, v94
v_cvt_pk_bf16_f32 v92, v92, v93
v_lshlrev_b32 v4, 2, v1
buffer_store_dword v92, v4, s[24:27], s19 offen
L_fin:
L_done:
s_endpgm
.section .rodata,"a"
.p2align 6
.amdhsa_kernel standalone__linear_kernel_rfa__decode_kernel
  .amdhsa_next_free_vgpr 244
  .amdhsa_next_free_sgpr 102
  .amdhsa_accum_offset 244
  .amdhsa_group_segment_fixed_size 0
  .amdhsa_kernarg_size 56
  .amdhsa_user_sgpr_count 2
  .amdhsa_user_sgpr_kernarg_segment_ptr 1
  .amdhsa_system_sgpr_workgroup_id_x 1
.end_amdhsa_kernel
```
